```python
import torch

def _softmax(x, axis=-1):
    return torch.softmax(x, dim=axis)
def _gelu(x):
    return torch.nn.functional.gelu(x, approximate="tanh")
def _silu(x):
    return torch.nn.functional.silu(x)
def _sigmoid(x):
    return torch.sigmoid(x)
def _layernorm(x, axis=-1, eps=1e-5):
    m = x.mean(dim=axis, keepdim=True)
    v = x.var(dim=axis, keepdim=True, unbiased=False)
    return (x - m) / torch.sqrt(v + eps)
def _scatter_add(tgt, idx, src, axis=0):
    return tgt.clone().index_add_(axis, idx, src)
def _segment_sum(src, seg, n):
    out = torch.zeros((n,) + src.shape[1:], dtype=src.dtype)
    return out.index_add_(0, seg, src)
def _pad(x, pw):
    flat = tuple(v for pair in reversed(pw) for v in pair)
    return torch.nn.functional.pad(x, flat)

kernel_name = 'gated_mix__sliding_block_cached__dense_activation_mish__decode'

def setup_inputs():

    _w = (lambda a: (lambda t: t.to(torch.bfloat16) if t.is_floating_point() else t)(torch.as_tensor(a)))
    def _A_setup():
        B, Sq, D = 1, 1, 512
        Hq, Hkv, Sk, Dh = 32, 8, 65536, 128
        assert Hq % Hkv == 0, (Hq, Hkv)
        return {
            "x": _w((lambda *s: torch.randn(*s, dtype=torch.bfloat16) * 0.05)(B, Sq, D)),
            "k_cache": _w((lambda *s: torch.randn(*s, dtype=torch.bfloat16) * 6.4)(B, Hkv, Sk, Dh)),
            "v_cache": _w((lambda *s: torch.randn(*s, dtype=torch.bfloat16) * 0.4)(B, Hkv, Sk, Dh)),
            "wq": _w((lambda *s: torch.randn(*s, dtype=torch.bfloat16) * 6.4)(D, Hq * Dh) * (D ** -0.5)),
            "wo": _w((lambda *s: torch.randn(*s, dtype=torch.bfloat16) * 0.4)(Hq * Dh, D) * ((Hq * Dh) ** -0.5)),
        }
    _A_in = _A_setup()

    def _B_setup():
        B, S, D, F = 1, 1, 512, 1792
        return {
            "x": _w((lambda *s: torch.randn(*s, dtype=torch.bfloat16) * 0.05)(B, S, D)),
            "w1": _w((lambda *s: torch.randn(*s, dtype=torch.bfloat16) * 12.8)(D, F) * (D ** -0.5)),
            "b1": _w((lambda *s: torch.randn(*s, dtype=torch.bfloat16) * 0.05)(F)),
            "w2": _w((lambda *s: torch.randn(*s, dtype=torch.bfloat16) * 0.05)(F, D) * (F ** -0.5)),
        }
    _B_in = _B_setup()

    return {
        "A_x": _A_in["x"],
        "A_k_cache": _A_in["k_cache"],
        "A_v_cache": _A_in["v_cache"],
        "A_wq": _A_in["wq"],
        "A_wo": _A_in["wo"],
        "B_x": _B_in["x"],
        "B_w1": _B_in["w1"],
        "B_b1": _B_in["b1"],
        "B_w2": _B_in["w2"],
        "gate_w": _w((lambda *s: torch.randn(*s, dtype=torch.bfloat16) * 0.05)(512) * 16.0),
    }

def reference(A_x, A_k_cache, A_v_cache, A_wq, A_wo, B_x, B_w1, B_b1, B_w2, gate_w):
    def _A_ref(x, k_cache, v_cache, wq, wo):
        B, Sq, D = x.shape
        Hq, Dh = 32, 128
        Hkv, Sk = k_cache.shape[1], k_cache.shape[2]
        W = min(4096, max(256, Sk // 4))
        rep = Hq // Hkv
        q = (lambda x, *d: x.permute(*d))((x @ wq).reshape(B, Sq, Hq, Dh), 0, 2, 1, 3)
        k = (lambda x, n, axis: torch.repeat_interleave(x, n, dim=axis))(k_cache[:, :, Sk - W:, :], rep, axis=1)
        v = (lambda x, n, axis: torch.repeat_interleave(x, n, dim=axis))(v_cache[:, :, Sk - W:, :], rep, axis=1)
        scores = torch.einsum("bhqd,bhkd->bhqk", q, k) * (Dh ** -0.5)
        p = _softmax(scores, axis=-1)
        o = torch.einsum("bhqk,bhkd->bhqd", p, v)
        return (lambda x, *d: x.permute(*d))(o, 0, 2, 1, 3).reshape(B, Sq, Hq * Dh) @ wo

    def _B_ref(x, w1, b1, w2):
        h = torch.einsum("bsd,df->bsf", x, w1) + b1
        sp = torch.log1p(torch.exp(-torch.abs(h))) + torch.where(h > 0, h, torch.zeros_like(h))
        act = h * torch.tanh(sp)
        return torch.einsum("bsf,fd->bsd", act, w2)

    x = A_x
    g = _sigmoid((x * gate_w).sum(-1, keepdims=True))
    a = _A_ref(x, A_k_cache, A_v_cache, A_wq, A_wo)
    b = _B_ref(x, B_w1, B_b1, B_w2)
    return g * a + (1 - g) * b
```

```asm
; @launch grid=(256,1,1) block=(384,1,1) lds=123392
.amdgcn_target "amdgcn-amd-amdhsa--gfx950"
.text
.globl gated_mix__sliding_block_cached__dense_activation_mish__decode_kernel
.p2align 12
.p2align 8
.type gated_mix__sliding_block_cached__dense_activation_mish__decode_kernel,@function
gated_mix__sliding_block_cached__dense_activation_mish__decode_kernel:
    s_load_dwordx16 s[8:23], s[0:1], 0
    s_load_dwordx8 s[24:31], s[0:1], 64
    s_load_dwordx2 s[32:33], s[0:1], 96
    v_readfirstlane_b32 s5, v0
    s_cmp_ge_u32 s2, 256
    s_cbranch_scc1 L_end
    s_and_b32 s3, s2, 7
    s_lshr_b32 s4, s2, 3
    s_lshr_b32 s6, s2, 6
    s_and_b32 s7, s4, 7
    s_lshr_b32 s5, s5, 6
    s_cbranch_scc0 L_loader
    v_and_b32 v0, 63, v0
    s_getpc_b64 s[62:63]
L_pc:
    s_and_b32 s41, s5, 3
    s_lshl2_add_u32 s40, s4, s41
    s_lshl_b32 s40, s40, 7
    s_min_u32 s40, s40, L_codeend-L_pc-128
    v_and_b32 v5, 1, v0
    v_lshl_add_u32 v5, v5, 6, s40
    global_load_dword v160, v5, s[62:63]
    v_and_b32 v2, 15, v0
    v_lshrrev_b32 v3, 4, v0
    v_lshlrev_b32 v4, 4, v0
    v_mov_b32 v14, 0
    s_mov_b32 s60, 100000
    v_mov_b32 v15, 0x3ff
    s_mov_b32 s47, 0x3fb8aa3b
    s_mov_b32 m0, 33536
    s_cmp_lg_u32 s5, 1
    s_waitcnt lgkmcnt(0)
    s_load_dword s34, s[32:33], 0
    s_cbranch_scc1 L_C
    global_load_lds_dwordx4 v4, s[8:9]
    s_lshl_b32 s40, s3, 13
    s_add_u32 s40, s40, 8192
    v_add_u32 v7, s40, v4
    s_lshl_b32 s41, s4, 8
    s_add_u32 s41, s41, s40
    v_lshl_add_u32 v6, v2, 4, s41
    s_lshl_b32 s40, s3, 9
    s_add_u32 s40, s40, 73728
    v_and_b32 v8, 31, v0
    v_lshl_add_u32 v8, v8, 4, s40
    s_lshl_b32 s41, s4, 4
    s_add_u32 s40, s40, s41
    v_mov_b32 v9, s40
    s_getreg_b32 s46, hwreg(HW_REG_XCC_ID, 0, 4)
    global_load_dword v18, v6, s[32:33]
    global_load_dwordx4 v[60:63], v4, s[26:27]
    s_branch L_aux2
L_loader:
    s_setprio 3
    s_lshl_b32 s40, s6, 20
    s_lshl_b32 s41, s3, 10
    s_add_u32 s40, s40, s41
    s_lshl_b32 s41, s7, 7
    s_add_u32 s40, s40, s41
    v_lshrrev_b32 v5, 3, v0
    v_lshlrev_b32 v5, 13, v5
    v_and_b32 v6, 7, v0
    v_lshl_add_u32 v5, v6, 4, v5
    v_add_u32 v16, s40, v5
    v_add_u32 v17, 64512, v16
    v_add_u32 v18, 129024, v16
    v_add_u32 v19, 193536, v16
    s_mov_b32 m0, 0
    s_waitcnt lgkmcnt(0)
    global_load_lds_dwordx4 v16, s[14:15] offset:0 nt
    global_load_lds_dwordx4 v17, s[14:15] offset:1024 nt
    global_load_lds_dwordx4 v18, s[14:15] offset:2048 nt
    global_load_lds_dwordx4 v19, s[14:15] offset:3072 nt
    s_mov_b32 m0, 4096
    s_add_u32 s14, s14, 0x40000
    s_addc_u32 s15, s15, 0
    global_load_lds_dwordx4 v16, s[14:15] offset:0 nt
    global_load_lds_dwordx4 v17, s[14:15] offset:1024 nt
    global_load_lds_dwordx4 v18, s[14:15] offset:2048 nt
    global_load_lds_dwordx4 v19, s[14:15] offset:3072 nt
    s_mov_b32 m0, 8192
    s_add_u32 s14, s14, 0x40000
    s_addc_u32 s15, s15, 0
    global_load_lds_dwordx4 v16, s[14:15] offset:0 nt
    global_load_lds_dwordx4 v17, s[14:15] offset:1024 nt
    global_load_lds_dwordx4 v18, s[14:15] offset:2048 nt
    global_load_lds_dwordx4 v19, s[14:15] offset:3072 nt
    s_mov_b32 m0, 12288
    s_add_u32 s14, s14, 0x40000
    s_addc_u32 s15, s15, 0
    global_load_lds_dwordx4 v16, s[14:15] offset:0 nt
    global_load_lds_dwordx4 v17, s[14:15] offset:1024 nt
    global_load_lds_dwordx4 v18, s[14:15] offset:2048 nt
    global_load_lds_dwordx4 v19, s[14:15] offset:3072 nt
    s_min_u32 s35, s7, 6
    s_mul_i32 s41, s3, 7
    s_add_u32 s35, s35, s41
    s_mul_i32 s40, s6, 458752
    s_lshl_b32 s41, s35, 6
    s_add_u32 s40, s40, s41
    v_lshrrev_b32 v5, 2, v0
    v_mul_u32_u24 v5, 3584, v5
    v_and_b32 v6, 3, v0
    v_lshl_add_u32 v5, v6, 4, v5
    v_add_u32 v32, s40, v5
    v_add_u32 v33, 56320, v32
    v_add_u32 v34, 112640, v32
    v_add_u32 v35, 168960, v32
    s_cmp_lt_u32 s7, 7
    s_cselect_b32 s22, 1835008, 0
    s_mov_b32 s23, 0x20000
    s_mov_b32 s46, 229376
    s_mov_b32 m0, 16896
    v_lshlrev_b32 v4, 4, v0
    buffer_load_dwordx4 v32, s[20:23], 0 offen offset:0 nt lds
    buffer_load_dwordx4 v33, s[20:23], 0 offen offset:1024 nt lds
    buffer_load_dwordx4 v34, s[20:23], 0 offen offset:2048 nt lds
    buffer_load_dwordx4 v35, s[20:23], 0 offen offset:3072 nt lds
    v_lshrrev_b32 v3, 4, v0
    v_mov_b32 v14, 0
    s_lshl_b32 s40, s3, 24
    s_lshl_b32 s41, s4, 12
    s_add_u32 s40, s40, s41
    s_add_u32 s40, s40, 15728640
    v_add_u32 v5, s40, v4
    s_sub_u32 s44, 8, s7
    v_lshlrev_b32 v6, 4, v3
    v_xor_b32 v46, v5, v6
    v_xor_b32 v47, 64, v46
    v_xor_b32 v48, 128, v46
    v_xor_b32 v49, 192, v46
    v_lshlrev_b32 v6, 5, v3
    v_xor_b32 v50, v5, v6
    v_xor_b32 v51, 128, v50
    s_mov_b32 s42, 102400
    s_mov_b32 s43, 0x21000
    v_lshrrev_b32 v5, 3, v0
    v_and_b32 v6, 6, v5
    v_xor_b32 v6, v0, v6
    v_and_b32 v6, 7, v6
    v_lshlrev_b32 v5, 10, v5
    v_lshl_add_u32 v5, v6, 4, v5
    s_lshl_b32 s41, s7, 7
    v_add_u32 v40, s41, v5
    v_add_u32 v41, 7168, v40
    v_add_u32 v42, 14336, v40
    v_add_u32 v43, 21504, v40
    s_lshl2_add_u32 s40, s3, s6
    s_lshl_b32 s41, s40, 17
    s_add_u32 s16, s16, s41
    s_addc_u32 s17, s17, 0
    s_mul_i32 s41, s40, 57344
    s_add_u32 s24, s24, s41
    s_addc_u32 s25, s25, 0
    s_lshl_b32 s36, s3, 5
    s_add_u32 s36, s36, s4
    s_mul_i32 s40, s36, 2176
    s_add_u32 s40, s40, 524288
    v_lshl_add_u32 v52, v0, 5, s40
    s_lshl_b32 s40, s3, 10
    s_add_u32 s40, s40, 491520
    v_add_u32 v53, s40, v4
    s_mov_b32 m0, 20992
    s_waitcnt vmcnt(19)
    buffer_load_dwordx4 v32, s[20:23], s46 offen offset:0 nt lds
    s_waitcnt vmcnt(19)
    buffer_load_dwordx4 v33, s[20:23], s46 offen offset:1024 nt lds
    s_waitcnt vmcnt(19)
    buffer_load_dwordx4 v34, s[20:23], s46 offen offset:2048 nt lds
    s_waitcnt vmcnt(19)
    buffer_load_dwordx4 v35, s[20:23], s46 offen offset:3072 nt lds
    s_mov_b32 m0, 40960
    s_waitcnt vmcnt(19)
    global_load_lds_dwordx4 v46, s[10:11] offset:0 nt
    s_waitcnt vmcnt(19)
    global_load_lds_dwordx4 v47, s[10:11] offset:1024 nt
    s_waitcnt vmcnt(19)
    global_load_lds_dwordx4 v48, s[10:11] offset:2048 nt
    s_waitcnt vmcnt(19)
    global_load_lds_dwordx4 v49, s[10:11] offset:3072 nt
    s_mov_b32 m0, 45056
    s_cmp_eq_u32 s44, 1
    s_cselect_b32 s45, s42, s43
    s_add_u32 s10, s10, s45
    s_addc_u32 s11, s11, 0
    s_waitcnt vmcnt(19)
    global_load_lds_dwordx4 v46, s[10:11] offset:0 nt
    s_waitcnt vmcnt(19)
    global_load_lds_dwordx4 v47, s[10:11] offset:1024 nt
    s_waitcnt vmcnt(19)
    global_load_lds_dwordx4 v48, s[10:11] offset:2048 nt
    s_waitcnt vmcnt(19)
    global_load_lds_dwordx4 v49, s[10:11] offset:3072 nt
    s_mov_b32 m0, 49152
    s_cmp_eq_u32 s44, 2
    s_cselect_b32 s45, s42, s43
    s_add_u32 s10, s10, s45
    s_addc_u32 s11, s11, 0
    s_waitcnt vmcnt(19)
    global_load_lds_dwordx4 v46, s[10:11] offset:0 nt
    s_waitcnt vmcnt(19)
    global_load_lds_dwordx4 v47, s[10:11] offset:1024 nt
    s_waitcnt vmcnt(19)
    global_load_lds_dwordx4 v48, s[10:11] offset:2048 nt
    s_waitcnt vmcnt(19)
    s_barrier
    global_load_lds_dwordx4 v49, s[10:11] offset:3072 nt
    s_mov_b32 m0, 53248
    s_cmp_eq_u32 s44, 3
    s_cselect_b32 s45, s42, s43
    s_add_u32 s10, s10, s45
    s_addc_u32 s11, s11, 0
    s_waitcnt vmcnt(19)
    global_load_lds_dwordx4 v46, s[10:11] offset:0 nt
    s_waitcnt vmcnt(19)
    global_load_lds_dwordx4 v47, s[10:11] offset:1024 nt
    s_waitcnt vmcnt(19)
    global_load_lds_dwordx4 v48, s[10:11] offset:2048 nt
    s_waitcnt vmcnt(19)
    global_load_lds_dwordx4 v49, s[10:11] offset:3072 nt
    s_mov_b32 m0, 57344
    s_cmp_eq_u32 s44, 4
    s_cselect_b32 s45, s42, s43
    s_add_u32 s10, s10, s45
    s_addc_u32 s11, s11, 0
    s_waitcnt vmcnt(19)
    global_load_lds_dwordx4 v46, s[10:11] offset:0 nt
    s_waitcnt vmcnt(19)
    global_load_lds_dwordx4 v47, s[10:11] offset:1024 nt
    s_waitcnt vmcnt(19)
    global_load_lds_dwordx4 v48, s[10:11] offset:2048 nt
    s_waitcnt vmcnt(19)
    global_load_lds_dwordx4 v49, s[10:11] offset:3072 nt
    v_mov_b32 v1, 24
    ds_write_b32 v14, v1 offset:40704
    s_mov_b32 m0, 61440
    s_cmp_eq_u32 s44, 5
    s_cselect_b32 s45, s42, s43
    s_add_u32 s10, s10, s45
    s_addc_u32 s11, s11, 0
    s_waitcnt vmcnt(19)
    global_load_lds_dwordx4 v46, s[10:11] offset:0 nt
    s_waitcnt vmcnt(19)
    global_load_lds_dwordx4 v47, s[10:11] offset:1024 nt
    s_waitcnt vmcnt(19)
    global_load_lds_dwordx4 v48, s[10:11] offset:2048 nt
    s_waitcnt vmcnt(19)
    global_load_lds_dwordx4 v49, s[10:11] offset:3072 nt
    s_mov_b32 m0, 65536
    s_cmp_eq_u32 s44, 6
    s_cselect_b32 s45, s42, s43
    s_add_u32 s10, s10, s45
    s_addc_u32 s11, s11, 0
    s_waitcnt vmcnt(19)
    global_load_lds_dwordx4 v46, s[10:11] offset:0 nt
    s_waitcnt vmcnt(19)
    global_load_lds_dwordx4 v47, s[10:11] offset:1024 nt
    s_waitcnt vmcnt(19)
    global_load_lds_dwordx4 v48, s[10:11] offset:2048 nt
    s_waitcnt vmcnt(19)
    global_load_lds_dwordx4 v49, s[10:11] offset:3072 nt
    v_mov_b32 v1, 32
    ds_write_b32 v14, v1 offset:40704
    s_mov_b32 m0, 69632
    s_cmp_eq_u32 s44, 7
    s_cselect_b32 s45, s42, s43
    s_add_u32 s10, s10, s45
    s_addc_u32 s11, s11, 0
    s_waitcnt vmcnt(19)
    global_load_lds_dwordx4 v46, s[10:11] offset:0 nt
    s_waitcnt vmcnt(19)
    global_load_lds_dwordx4 v47, s[10:11] offset:1024 nt
    s_waitcnt vmcnt(19)
    global_load_lds_dwordx4 v48, s[10:11] offset:2048 nt
    s_waitcnt vmcnt(19)
    global_load_lds_dwordx4 v49, s[10:11] offset:3072 nt
    s_waitcnt vmcnt(19)
    global_load_dword v7, v52, s[32:33]
    s_waitcnt vmcnt(19)
    global_load_dword v7, v53, s[32:33]
    s_mov_b32 m0, 73728
    s_waitcnt vmcnt(19)
    global_load_lds_dwordx4 v50, s[12:13] offset:0 nt
    s_waitcnt vmcnt(19)
    global_load_lds_dwordx4 v51, s[12:13] offset:1024 nt
    v_mov_b32 v1, 40
    ds_write_b32 v14, v1 offset:40704
    s_waitcnt vmcnt(19)
    global_load_lds_dwordx4 v50, s[12:13] offset:2048 nt
    s_waitcnt vmcnt(19)
    global_load_lds_dwordx4 v51, s[12:13] offset:3072 nt
    s_mov_b32 m0, 77824
    s_cmp_eq_u32 s44, 1
    s_cselect_b32 s45, s42, s43
    s_add_u32 s12, s12, s45
    s_addc_u32 s13, s13, 0
    s_waitcnt vmcnt(19)
    global_load_lds_dwordx4 v50, s[12:13] offset:0 nt
    s_waitcnt vmcnt(19)
    global_load_lds_dwordx4 v51, s[12:13] offset:1024 nt
    s_waitcnt vmcnt(19)
    global_load_lds_dwordx4 v50, s[12:13] offset:2048 nt
    s_waitcnt vmcnt(19)
    global_load_lds_dwordx4 v51, s[12:13] offset:3072 nt
    s_mov_b32 m0, 81920
    s_cmp_eq_u32 s44, 2
    s_cselect_b32 s45, s42, s43
    s_add_u32 s12, s12, s45
    s_addc_u32 s13, s13, 0
    s_waitcnt vmcnt(19)
    global_load_lds_dwordx4 v50, s[12:13] offset:0 nt
    s_waitcnt vmcnt(19)
    global_load_lds_dwordx4 v51, s[12:13] offset:1024 nt
    v_mov_b32 v1, 48
    ds_write_b32 v14, v1 offset:40704
    s_waitcnt vmcnt(19)
    global_load_lds_dwordx4 v50, s[12:13] offset:2048 nt
    s_waitcnt vmcnt(19)
    global_load_lds_dwordx4 v51, s[12:13] offset:3072 nt
    s_mov_b32 m0, 86016
    s_cmp_eq_u32 s44, 3
    s_cselect_b32 s45, s42, s43
    s_add_u32 s12, s12, s45
    s_addc_u32 s13, s13, 0
    s_waitcnt vmcnt(19)
    global_load_lds_dwordx4 v50, s[12:13] offset:0 nt
    s_waitcnt vmcnt(19)
    global_load_lds_dwordx4 v51, s[12:13] offset:1024 nt
    s_waitcnt vmcnt(19)
    global_load_lds_dwordx4 v50, s[12:13] offset:2048 nt
    s_waitcnt vmcnt(19)
    global_load_lds_dwordx4 v51, s[12:13] offset:3072 nt
    s_mov_b32 m0, 90112
    s_cmp_eq_u32 s44, 4
    s_cselect_b32 s45, s42, s43
    s_add_u32 s12, s12, s45
    s_addc_u32 s13, s13, 0
    s_waitcnt vmcnt(19)
    global_load_lds_dwordx4 v50, s[12:13] offset:0 nt
    s_waitcnt vmcnt(19)
    global_load_lds_dwordx4 v51, s[12:13] offset:1024 nt
    v_mov_b32 v1, 56
    ds_write_b32 v14, v1 offset:40704
    s_waitcnt vmcnt(19)
    global_load_lds_dwordx4 v50, s[12:13] offset:2048 nt
    s_waitcnt vmcnt(19)
    global_load_lds_dwordx4 v51, s[12:13] offset:3072 nt
    s_mov_b32 m0, 94208
    s_cmp_eq_u32 s44, 5
    s_cselect_b32 s45, s42, s43
    s_add_u32 s12, s12, s45
    s_addc_u32 s13, s13, 0
    s_waitcnt vmcnt(19)
    global_load_lds_dwordx4 v50, s[12:13] offset:0 nt
    s_waitcnt vmcnt(19)
    global_load_lds_dwordx4 v51, s[12:13] offset:1024 nt
    s_waitcnt vmcnt(19)
    global_load_lds_dwordx4 v50, s[12:13] offset:2048 nt
    s_waitcnt vmcnt(19)
    global_load_lds_dwordx4 v51, s[12:13] offset:3072 nt
    s_mov_b32 m0, 98304
    s_cmp_eq_u32 s44, 6
    s_cselect_b32 s45, s42, s43
    s_add_u32 s12, s12, s45
    s_addc_u32 s13, s13, 0
    s_waitcnt vmcnt(19)
    global_load_lds_dwordx4 v50, s[12:13] offset:0 nt
    s_waitcnt vmcnt(19)
    global_load_lds_dwordx4 v51, s[12:13] offset:1024 nt
    s_waitcnt vmcnt(19)
    global_load_lds_dwordx4 v50, s[12:13] offset:2048 nt
    s_waitcnt vmcnt(19)
    global_load_lds_dwordx4 v51, s[12:13] offset:3072 nt
    s_mov_b32 m0, 102400
    s_cmp_eq_u32 s44, 7
    s_cselect_b32 s45, s42, s43
    s_add_u32 s12, s12, s45
    s_addc_u32 s13, s13, 0
    s_waitcnt vmcnt(19)
    global_load_lds_dwordx4 v50, s[12:13] offset:0 nt
    s_waitcnt vmcnt(19)
    global_load_lds_dwordx4 v51, s[12:13] offset:1024 nt
    s_waitcnt vmcnt(19)
    global_load_lds_dwordx4 v50, s[12:13] offset:2048 nt
    s_waitcnt vmcnt(19)
    global_load_lds_dwordx4 v51, s[12:13] offset:3072 nt
    s_mov_b32 m0, 25088
    s_waitcnt vmcnt(19)
    global_load_lds_dwordx4 v40, s[24:25] offset:0 nt
    s_waitcnt vmcnt(19)
    global_load_lds_dwordx4 v41, s[24:25] offset:1024 nt
    s_waitcnt vmcnt(19)
    global_load_lds_dwordx4 v42, s[24:25] offset:2048 nt
    s_waitcnt vmcnt(19)
    global_load_lds_dwordx4 v43, s[24:25] offset:3072 nt
    s_mov_b32 m0, 29184
    s_add_u32 s24, s24, 0x8000
    s_addc_u32 s25, s25, 0
    s_waitcnt vmcnt(19)
    global_load_lds_dwordx4 v40, s[24:25] offset:0 nt
    s_waitcnt vmcnt(19)
    global_load_lds_dwordx4 v41, s[24:25] offset:1024 nt
    s_waitcnt vmcnt(19)
    global_load_lds_dwordx4 v42, s[24:25] offset:2048 nt
    s_mov_b32 m0, 106496
    s_waitcnt vmcnt(19)
    global_load_lds_dwordx4 v40, s[16:17] offset:0 nt
    s_waitcnt vmcnt(19)
    global_load_lds_dwordx4 v41, s[16:17] offset:1024 nt
    s_waitcnt vmcnt(19)
    global_load_lds_dwordx4 v42, s[16:17] offset:2048 nt
    s_waitcnt vmcnt(19)
    global_load_lds_dwordx4 v43, s[16:17] offset:3072 nt
    s_mov_b32 m0, 110592
    s_add_u32 s16, s16, 0x8000
    s_addc_u32 s17, s17, 0
    s_waitcnt vmcnt(19)
    global_load_lds_dwordx4 v40, s[16:17] offset:0 nt
    v_mov_b32 v1, 82
    ds_write_b32 v14, v1 offset:40704
    s_waitcnt vmcnt(19)
    global_load_lds_dwordx4 v41, s[16:17] offset:1024 nt
    s_waitcnt vmcnt(19)
    global_load_lds_dwordx4 v42, s[16:17] offset:2048 nt
    s_waitcnt vmcnt(19)
    global_load_lds_dwordx4 v43, s[16:17] offset:3072 nt
    s_mov_b32 m0, 114688
    s_add_u32 s16, s16, 0x8000
    s_addc_u32 s17, s17, 0
    s_waitcnt vmcnt(19)
    global_load_lds_dwordx4 v40, s[16:17] offset:0 nt
    s_waitcnt vmcnt(19)
    global_load_lds_dwordx4 v41, s[16:17] offset:1024 nt
    s_waitcnt vmcnt(19)
    global_load_lds_dwordx4 v42, s[16:17] offset:2048 nt
    s_waitcnt vmcnt(19)
    global_load_lds_dwordx4 v43, s[16:17] offset:3072 nt
    s_mov_b32 m0, 118784
    s_add_u32 s16, s16, 0x8000
    s_addc_u32 s17, s17, 0
    s_waitcnt vmcnt(19)
    global_load_lds_dwordx4 v40, s[16:17] offset:0 nt
    v_mov_b32 v1, 90
    ds_write_b32 v14, v1 offset:40704
    s_waitcnt vmcnt(19)
    global_load_lds_dwordx4 v41, s[16:17] offset:1024 nt
    s_waitcnt vmcnt(19)
    global_load_lds_dwordx4 v42, s[16:17] offset:2048 nt
    s_waitcnt vmcnt(19)
    global_load_lds_dwordx4 v43, s[16:17] offset:3072 nt
    s_waitcnt vmcnt(16)
    v_mov_b32 v1, 97
    ds_write_b32 v14, v1 offset:40704
    s_waitcnt vmcnt(0)
    v_mov_b32 v1, 113
    ds_write_b32 v14, v1 offset:40704
    s_endpgm
    .p2align 12
L_aux2:
    v_min_u32 v11, 55, v0
    s_mul_i32 s38, s6, 56
    v_add_u32 v11, s38, v11
    s_mul_i32 s40, s3, 224
    v_add_lshl_u32 v12, v11, s40, 1
    global_load_ushort v42, v12, s[22:23]
    v_lshlrev_b32 v5, 2, v0
    ds_write_b32 v5, v14 offset:40704
    v_mov_b32 v24, 0
    v_mov_b32 v25, 0
    v_mov_b32 v26, 0
    v_mov_b32 v27, 0
    ds_write_b128 v4, v[24:27] offset:32256
    s_lshl_b32 s40, s3, 13
    s_add_u32 s40, s40, 77824
    v_lshrrev_b32 v43, 5, v11
    v_lshlrev_b32 v43, 10, v43
    v_and_b32 v11, 31, v11
    v_lshl_add_u32 v43, v11, 3, v43
    v_add_u32 v43, s40, v43
    s_lshl_b32 s41, s7, 10
    s_add_u32 s40, s40, s41
    s_lshl_b32 s41, s6, 8
    s_add_u32 s41, s41, s40
    v_lshl_add_u32 v10, v0, 3, s41
    v_add_u32 v6, 196608, v6
    v_lshrrev_b32 v11, 2, v2
    v_lshl_add_u32 v11, v3, 3, v11
    v_and_b32 v17, 3, v2
    v_lshlrev_b32 v17, 3, v17
    v_lshl_add_u32 v19, v11, 6, v17
    s_lshl_b32 s40, s6, 8
    v_lshl_add_u32 v11, v3, 4, s40
    v_add_u32 v12, 4096, v7
    v_lshlrev_b32 v13, 3, v0
    s_waitcnt lgkmcnt(0)
    s_mul_i32 s34, s34, 1664525
    s_add_u32 s34, s34, 1013904223
    s_and_b32 s50, s34, 0x3ff
    s_bfe_u32 s51, s34, 0xa0008
    s_bfe_u32 s52, s34, 0xa000f
    s_lshr_b32 s53, s34, 22
    s_and_b32 s50, s50, 0xff
    s_and_b32 s51, s51, 0xff
    s_and_b32 s52, s52, 0xff
    s_and_b32 s53, s53, 0xff
    s_lshl_b32 s55, s46, 10
    s_or_b32 s55, s55, s50
    v_mov_b32 v20, s55
    v_mov_b32 v21, s51
    v_mov_b32 v22, s52
    v_mov_b32 v23, s53
    s_mov_b64 exec, 1
    global_store_dwordx4 v9, v[20:23], s[32:33] sc1
    s_mov_b64 exec, -1
    s_mov_b32 s59, 196608
    s_waitcnt vmcnt(4)
    s_barrier
    ds_read_b128 v[64:67], v4 offset:33536
    ds_read_b128 v[44:47], v11 offset:33536
    ds_read_b128 v[48:51], v11 offset:33600
    ds_read_b128 v[52:55], v11 offset:33664
    ds_read_b128 v[56:59], v11 offset:33728
L_sp1:
    ds_read_b32 v1, v14 offset:40704
    s_waitcnt lgkmcnt(0)
    v_cmp_gt_u32 vcc, 24, v1
    s_cbranch_vccnz L_sp1
    ds_read_b64_tr_b16 v[68:69], v19 offset:16896
    ds_read_b64_tr_b16 v[70:71], v19 offset:17152
    ds_read_b64_tr_b16 v[72:73], v19 offset:16928
    ds_read_b64_tr_b16 v[74:75], v19 offset:17184
    ds_read_b64_tr_b16 v[76:77], v19 offset:18944
    ds_read_b64_tr_b16 v[78:79], v19 offset:19200
    ds_read_b64_tr_b16 v[80:81], v19 offset:18976
    ds_read_b64_tr_b16 v[82:83], v19 offset:19232
    ds_read_b64_tr_b16 v[84:85], v19 offset:20992
    ds_read_b64_tr_b16 v[86:87], v19 offset:21248
    ds_read_b64_tr_b16 v[88:89], v19 offset:21024
    ds_read_b64_tr_b16 v[90:91], v19 offset:21280
    ds_read_b64_tr_b16 v[92:93], v19 offset:23040
    ds_read_b64_tr_b16 v[94:95], v19 offset:23296
    ds_read_b64_tr_b16 v[96:97], v19 offset:23072
    ds_read_b64_tr_b16 v[98:99], v19 offset:23328
    s_waitcnt lgkmcnt(12)
    v_mfma_f32_16x16x32_bf16 v[32:35], v[44:47], v[68:71], 0
    v_mfma_f32_16x16x32_bf16 v[36:39], v[44:47], v[72:75], 0
    s_waitcnt lgkmcnt(8)
    v_mfma_f32_16x16x32_bf16 v[32:35], v[48:51], v[76:79], v[32:35]
    v_mfma_f32_16x16x32_bf16 v[36:39], v[48:51], v[80:83], v[36:39]
    s_waitcnt lgkmcnt(4)
    v_mfma_f32_16x16x32_bf16 v[32:35], v[52:55], v[84:87], v[32:35]
    v_mfma_f32_16x16x32_bf16 v[36:39], v[52:55], v[88:91], v[36:39]
    s_waitcnt lgkmcnt(0)
    v_mfma_f32_16x16x32_bf16 v[32:35], v[56:59], v[92:95], v[32:35]
    v_mfma_f32_16x16x32_bf16 v[36:39], v[56:59], v[96:99], v[36:39]
    s_mov_b32 exec_hi, 0
    s_mov_b32 exec_lo, 0xffff0000
    s_nop 5
    v_mov_b32 v32, v36
    s_mov_b32 exec_lo, -1
    v_mov_b32 v33, s34
    global_store_dwordx2 v10, v[32:33], s[32:33] sc1
    s_mov_b32 exec_hi, -1
L_sp2:
    ds_read_b32 v1, v14 offset:40708
    s_waitcnt lgkmcnt(0)
    v_cmp_gt_u32 vcc, 4, v1
    s_cbranch_vccnz L_sp2
    ds_read_b128 v[36:39], v4 offset:16384
    v_mov_b32 v16, 0
    s_mov_b64 exec, 0xffff
    s_waitcnt lgkmcnt(0)
    global_store_dwordx4 v6, v[36:39], s[32:33] sc1
    s_mov_b64 exec, -1
    s_waitcnt vmcnt(3)
    v_lshlrev_b32 v17, 16, v60
    v_lshlrev_b32 v18, 16, v64
    v_and_b32 v41, 0xffff0000, v60
    v_and_b32 v40, 0xffff0000, v64
    v_mul_f32 v17, v17, v18
    v_mul_f32 v41, v41, v40
    v_cvt_pk_bf16_f32 v17, v17, v41
    v_lshlrev_b32 v18, 16, v17
    v_and_b32 v41, 0xffff0000, v17
    v_add_f32 v16, v16, v18
    v_add_f32 v16, v16, v41
    v_lshlrev_b32 v17, 16, v61
    v_lshlrev_b32 v18, 16, v65
    v_and_b32 v41, 0xffff0000, v61
    v_and_b32 v40, 0xffff0000, v65
    v_mul_f32 v17, v17, v18
    v_mul_f32 v41, v41, v40
    v_cvt_pk_bf16_f32 v17, v17, v41
    v_lshlrev_b32 v18, 16, v17
    v_and_b32 v41, 0xffff0000, v17
    v_add_f32 v16, v16, v18
    v_add_f32 v16, v16, v41
    v_lshlrev_b32 v17, 16, v62
    v_lshlrev_b32 v18, 16, v66
    v_and_b32 v41, 0xffff0000, v62
    v_and_b32 v40, 0xffff0000, v66
    v_mul_f32 v17, v17, v18
    v_mul_f32 v41, v41, v40
    v_cvt_pk_bf16_f32 v17, v17, v41
    v_lshlrev_b32 v18, 16, v17
    v_and_b32 v41, 0xffff0000, v17
    v_add_f32 v16, v16, v18
    v_add_f32 v16, v16, v41
    v_lshlrev_b32 v17, 16, v63
    v_lshlrev_b32 v18, 16, v67
    v_and_b32 v41, 0xffff0000, v63
    v_and_b32 v40, 0xffff0000, v67
    v_mul_f32 v17, v17, v18
    v_mul_f32 v41, v41, v40
    v_cvt_pk_bf16_f32 v17, v17, v41
    v_lshlrev_b32 v18, 16, v17
    v_and_b32 v41, 0xffff0000, v17
    v_add_f32 v16, v16, v18
    v_add_f32 v16, v16, v41
    v_mov_b32 v17, v16
    s_nop 1
    v_permlane32_swap_b32 v16, v17
    v_add_f32 v16, v16, v17
    v_mov_b32 v17, v16
    s_nop 1
    v_permlane16_swap_b32 v16, v17
    v_add_f32 v16, v16, v17
    s_nop 1
    v_add_f32_dpp v16, v16, v16 row_ror:1 row_mask:0xf bank_mask:0xf
    s_nop 1
    v_add_f32_dpp v16, v16, v16 row_ror:2 row_mask:0xf bank_mask:0xf
    s_nop 1
    v_add_f32_dpp v16, v16, v16 row_ror:4 row_mask:0xf bank_mask:0xf
    s_nop 1
    v_add_f32_dpp v16, v16, v16 row_ror:8 row_mask:0xf bank_mask:0xf
    v_cvt_pk_bf16_f32 v16, v16, v16
    v_lshlrev_b32 v16, 16, v16
    v_mul_f32 v16, s47, v16
    v_exp_f32 v16, -v16
    s_nop 0
    v_add_f32 v16, 1.0, v16
    v_rcp_f32 v16, v16
    s_nop 0
    v_cvt_pk_bf16_f32 v16, v16, v16
    v_lshlrev_b32 v16, 16, v16
    v_sub_f32 v17, 1.0, v16
    v_cvt_pk_bf16_f32 v17, v17, v17
    v_lshlrev_b32 v17, 16, v17
    v_mov_b32 v19, 1
L_sp3:
    ds_read_b32 v1, v14 offset:40704
    s_waitcnt lgkmcnt(0)
    v_cmp_gt_u32 vcc, 40, v1
    s_cbranch_vccnz L_sp3
    global_load_dwordx4 v[104:107], v7, s[32:33] offset:0 sc1
    global_load_dwordx4 v[108:111], v7, s[32:33] offset:1024 sc1
    global_load_dwordx4 v[112:115], v7, s[32:33] offset:2048 sc1
    global_load_dwordx4 v[116:119], v7, s[32:33] offset:3072 sc1
    global_load_dwordx4 v[120:123], v12, s[32:33] offset:0 sc1
    global_load_dwordx4 v[124:127], v12, s[32:33] offset:1024 sc1
    global_load_dwordx4 v[128:131], v12, s[32:33] offset:2048 sc1
    global_load_dwordx4 v[132:135], v12, s[32:33] offset:3072 sc1
    global_load_dwordx4 v[136:139], v8, s[32:33] sc1
L_sp4:
    ds_read_b32 v1, v14 offset:40704
    s_waitcnt lgkmcnt(0)
    v_cmp_gt_u32 vcc, 48, v1
    s_cbranch_vccnz L_sp4
L_pp:
    global_load_dwordx4 v[68:71], v7, s[32:33] offset:0 sc1
    global_load_dwordx4 v[72:75], v7, s[32:33] offset:1024 sc1
    global_load_dwordx4 v[76:79], v7, s[32:33] offset:2048 sc1
    global_load_dwordx4 v[80:83], v7, s[32:33] offset:3072 sc1
    global_load_dwordx4 v[84:87], v12, s[32:33] offset:0 sc1
    global_load_dwordx4 v[88:91], v12, s[32:33] offset:1024 sc1
    global_load_dwordx4 v[92:95], v12, s[32:33] offset:2048 sc1
    global_load_dwordx4 v[96:99], v12, s[32:33] offset:3072 sc1
    global_load_dwordx4 v[100:103], v8, s[32:33] sc1
    s_waitcnt vmcnt(17)
    v_xor_b32 v104, s50, v104
    v_xor_b32 v105, s51, v105
    v_xor_b32 v106, s52, v106
    v_xor_b32 v107, s53, v107
    v_or_b32 v60, v104, v105
    v_or3_b32 v60, v60, v106, v107
    s_waitcnt vmcnt(16)
    v_xor_b32 v108, s50, v108
    v_xor_b32 v109, s51, v109
    v_xor_b32 v110, s52, v110
    v_xor_b32 v111, s53, v111
    v_or3_b32 v60, v60, v108, v109
    v_or3_b32 v60, v60, v110, v111
    s_waitcnt vmcnt(15)
    v_xor_b32 v112, s50, v112
    v_xor_b32 v113, s51, v113
    v_xor_b32 v114, s52, v114
    v_xor_b32 v115, s53, v115
    v_or3_b32 v60, v60, v112, v113
    v_or3_b32 v60, v60, v114, v115
    v_pk_add_f32 v[24:25], v[112:113], v[104:105]
    v_pk_add_f32 v[26:27], v[114:115], v[106:107]
    s_waitcnt vmcnt(14)
    v_xor_b32 v116, s50, v116
    v_xor_b32 v117, s51, v117
    v_xor_b32 v118, s52, v118
    v_xor_b32 v119, s53, v119
    v_or3_b32 v60, v60, v116, v117
    v_or3_b32 v60, v60, v118, v119
    v_pk_add_f32 v[28:29], v[116:117], v[108:109]
    v_pk_add_f32 v[30:31], v[118:119], v[110:111]
    s_waitcnt vmcnt(13)
    v_xor_b32 v120, s50, v120
    v_xor_b32 v121, s51, v121
    v_xor_b32 v122, s52, v122
    v_xor_b32 v123, s53, v123
    v_or3_b32 v60, v60, v120, v121
    v_or3_b32 v60, v60, v122, v123
    v_pk_add_f32 v[24:25], v[120:121], v[24:25]
    v_pk_add_f32 v[26:27], v[122:123], v[26:27]
    s_waitcnt vmcnt(12)
    v_xor_b32 v124, s50, v124
    v_xor_b32 v125, s51, v125
    v_xor_b32 v126, s52, v126
    v_xor_b32 v127, s53, v127
    v_or3_b32 v60, v60, v124, v125
    v_or3_b32 v60, v60, v126, v127
    v_pk_add_f32 v[28:29], v[124:125], v[28:29]
    v_pk_add_f32 v[30:31], v[126:127], v[30:31]
    s_waitcnt vmcnt(11)
    v_xor_b32 v128, s50, v128
    v_xor_b32 v129, s51, v129
    v_xor_b32 v130, s52, v130
    v_xor_b32 v131, s53, v131
    v_or3_b32 v60, v60, v128, v129
    v_or3_b32 v60, v60, v130, v131
    v_pk_add_f32 v[24:25], v[128:129], v[24:25]
    v_pk_add_f32 v[26:27], v[130:131], v[26:27]
    s_waitcnt vmcnt(10)
    v_xor_b32 v132, s50, v132
    v_xor_b32 v133, s51, v133
    v_xor_b32 v134, s52, v134
    v_xor_b32 v135, s53, v135
    v_or3_b32 v60, v60, v132, v133
    v_or3_b32 v60, v60, v134, v135
    v_pk_add_f32 v[28:29], v[132:133], v[28:29]
    v_pk_add_f32 v[30:31], v[134:135], v[30:31]
    s_waitcnt vmcnt(9)
    v_xor_b32 v136, s50, v136
    v_xor_b32 v137, s51, v137
    v_xor_b32 v138, s52, v138
    v_xor_b32 v139, s53, v139
    v_or3_b32 v60, v60, v136, v137
    v_or3_b32 v60, v60, v138, v139
    v_lshrrev_b32 v18, 10, v136
    v_and_b32 v60, 0xff, v60
    v_cmp_ne_u32 vcc, 0, v60
    s_cbranch_vccz L_ok1
    v_or3_b32 v61, v136, v137, v138
    v_or_b32 v61, v61, v139
    v_and_b32 v61, 0xff, v61
    v_cmp_eq_u32 vcc, 0, v61
    v_cmp_ne_u32 s[40:41], s46, v18
    s_and_b64 vcc, vcc, s[40:41]
    s_cbranch_scc0 L_g1
    v_add_u32 v7, s59, v7
    v_add_u32 v12, s59, v12
    s_mov_b32 s59, 0
L_g1:
    global_load_dwordx4 v[104:107], v7, s[32:33] offset:0 sc1
    global_load_dwordx4 v[108:111], v7, s[32:33] offset:1024 sc1
    global_load_dwordx4 v[112:115], v7, s[32:33] offset:2048 sc1
    global_load_dwordx4 v[116:119], v7, s[32:33] offset:3072 sc1
    global_load_dwordx4 v[120:123], v12, s[32:33] offset:0 sc1
    global_load_dwordx4 v[124:127], v12, s[32:33] offset:1024 sc1
    global_load_dwordx4 v[128:131], v12, s[32:33] offset:2048 sc1
    global_load_dwordx4 v[132:135], v12, s[32:33] offset:3072 sc1
    global_load_dwordx4 v[136:139], v8, s[32:33] sc1
    s_waitcnt vmcnt(17)
    v_xor_b32 v68, s50, v68
    v_xor_b32 v69, s51, v69
    v_xor_b32 v70, s52, v70
    v_xor_b32 v71, s53, v71
    v_or_b32 v60, v68, v69
    v_or3_b32 v60, v60, v70, v71
    s_waitcnt vmcnt(16)
    v_xor_b32 v72, s50, v72
    v_xor_b32 v73, s51, v73
    v_xor_b32 v74, s52, v74
    v_xor_b32 v75, s53, v75
    v_or3_b32 v60, v60, v72, v73
    v_or3_b32 v60, v60, v74, v75
    s_waitcnt vmcnt(15)
    v_xor_b32 v76, s50, v76
    v_xor_b32 v77, s51, v77
    v_xor_b32 v78, s52, v78
    v_xor_b32 v79, s53, v79
    v_or3_b32 v60, v60, v76, v77
    v_or3_b32 v60, v60, v78, v79
    v_pk_add_f32 v[24:25], v[76:77], v[68:69]
    v_pk_add_f32 v[26:27], v[78:79], v[70:71]
    s_waitcnt vmcnt(14)
    v_xor_b32 v80, s50, v80
    v_xor_b32 v81, s51, v81
    v_xor_b32 v82, s52, v82
    v_xor_b32 v83, s53, v83
    v_or3_b32 v60, v60, v80, v81
    v_or3_b32 v60, v60, v82, v83
    v_pk_add_f32 v[28:29], v[80:81], v[72:73]
    v_pk_add_f32 v[30:31], v[82:83], v[74:75]
    s_waitcnt vmcnt(13)
    v_xor_b32 v84, s50, v84
    v_xor_b32 v85, s51, v85
    v_xor_b32 v86, s52, v86
    v_xor_b32 v87, s53, v87
    v_or3_b32 v60, v60, v84, v85
    v_or3_b32 v60, v60, v86, v87
    v_pk_add_f32 v[24:25], v[84:85], v[24:25]
    v_pk_add_f32 v[26:27], v[86:87], v[26:27]
    s_waitcnt vmcnt(12)
    v_xor_b32 v88, s50, v88
    v_xor_b32 v89, s51, v89
    v_xor_b32 v90, s52, v90
    v_xor_b32 v91, s53, v91
    v_or3_b32 v60, v60, v88, v89
    v_or3_b32 v60, v60, v90, v91
    v_pk_add_f32 v[28:29], v[88:89], v[28:29]
    v_pk_add_f32 v[30:31], v[90:91], v[30:31]
    s_waitcnt vmcnt(11)
    v_xor_b32 v92, s50, v92
    v_xor_b32 v93, s51, v93
    v_xor_b32 v94, s52, v94
    v_xor_b32 v95, s53, v95
    v_or3_b32 v60, v60, v92, v93
    v_or3_b32 v60, v60, v94, v95
    v_pk_add_f32 v[24:25], v[92:93], v[24:25]
    v_pk_add_f32 v[26:27], v[94:95], v[26:27]
    s_waitcnt vmcnt(10)
    v_xor_b32 v96, s50, v96
    v_xor_b32 v97, s51, v97
    v_xor_b32 v98, s52, v98
    v_xor_b32 v99, s53, v99
    v_or3_b32 v60, v60, v96, v97
    v_or3_b32 v60, v60, v98, v99
    v_pk_add_f32 v[28:29], v[96:97], v[28:29]
    v_pk_add_f32 v[30:31], v[98:99], v[30:31]
    s_waitcnt vmcnt(9)
    v_xor_b32 v100, s50, v100
    v_xor_b32 v101, s51, v101
    v_xor_b32 v102, s52, v102
    v_xor_b32 v103, s53, v103
    v_or3_b32 v60, v60, v100, v101
    v_or3_b32 v60, v60, v102, v103
    v_lshrrev_b32 v18, 10, v100
    v_and_b32 v60, 0xff, v60
    v_cmp_ne_u32 vcc, 0, v60
    s_cbranch_vccz L_ok1
    s_sub_u32 s60, s60, 1
    s_cmp_gt_i32 s60, 0
    s_cbranch_scc1 L_pp
L_ok1:
    v_cvt_pk_bf16_f32 v24, v24, v25
    v_cvt_pk_bf16_f32 v25, v26, v27
    v_cvt_pk_bf16_f32 v26, v28, v29
    v_cvt_pk_bf16_f32 v27, v30, v31
    v_cmp_ne_u32 vcc, s46, v18
    ds_write_b64 v13, v[24:25] offset:34560
    ds_write_b64 v13, v[26:27] offset:35072
    s_cmp_lg_u64 vcc, 0
    s_cselect_b32 s40, 1, 0
    v_mov_b32 v18, s40
    ds_write_b128 v14, v[16:19] offset:40720
L_pollh:
    global_load_dwordx2 v[20:21], v43, s[32:33] sc1
    global_load_dwordx2 v[22:23], v43, s[32:33] offset:256 sc1
    global_load_dwordx2 v[24:25], v43, s[32:33] offset:512 sc1
    global_load_dwordx2 v[26:27], v43, s[32:33] offset:768 sc1
    s_waitcnt vmcnt(0)
    v_xor_b32 v16, s34, v21
    v_bitop3_b32 v16, v23, s34, v16 bitop3:0xbe
    v_bitop3_b32 v16, v25, s34, v16 bitop3:0xbe
    v_bitop3_b32 v16, v27, s34, v16 bitop3:0xbe
    v_cmp_ne_u32 vcc, 0, v16
    s_cbranch_vccz L_okh
    s_sub_u32 s60, s60, 1
    s_cmp_gt_i32 s60, 0
    s_cbranch_scc1 L_pollh
L_okh:
    v_add_f32 v20, v20, v22
    v_add_f32 v24, v24, v26
    s_mov_b32 s46, 0x3f317218
    s_mov_b32 s55, 0x3a800000
    v_add_f32 v20, v20, v24
    v_lshlrev_b32 v42, 16, v42
    v_cvt_pk_bf16_f32 v16, v20, v20
    v_lshlrev_b32 v16, 16, v16
    v_add_f32 v16, v16, v42
    v_cvt_pk_bf16_f32 v16, v16, v16
    v_lshlrev_b32 v16, 16, v16
    v_mul_f32 v17, s47, v16
    v_exp_f32 v17, -abs(v17)
    s_nop 0
    v_cvt_pk_bf16_f32 v17, v17, v17
    v_lshlrev_b32 v17, 16, v17
    v_add_f32 v18, 1.0, v17
    v_log_f32 v22, v18
    v_subrev_f32 v20, 1.0, v18
    v_rcp_f32 v21, v20
    v_mul_f32 v22, s46, v22
    v_cmp_eq_f32 vcc, 0, v20
    v_mul_f32 v21, v17, v21
    v_mul_f32 v22, v22, v21
    v_cndmask_b32 v22, v22, v17, vcc
    v_cvt_pk_bf16_f32 v22, v22, v22
    v_lshlrev_b32 v22, 16, v22
    v_max_f32 v20, 0, v16
    v_add_f32 v22, v22, v20
    v_cvt_pk_bf16_f32 v22, v22, v22
    v_lshlrev_b32 v22, 16, v22
    v_mul_f32 v20, s47, v22
    v_mul_f32 v20, -2.0, v20
    v_exp_f32 v20, v20
    v_cmp_gt_f32 vcc, s55, v22
    v_add_f32 v21, 1.0, v20
    v_rcp_f32 v21, v21
    v_sub_f32 v20, 1.0, v20
    v_mul_f32 v20, v20, v21
    v_cndmask_b32 v20, v20, v22, vcc
    v_cvt_pk_bf16_f32 v20, v20, v20
    v_lshlrev_b32 v20, 16, v20
    v_mul_f32 v20, v16, v20
    v_cmp_gt_u32 vcc, 56, v0
    v_cvt_pk_bf16_f32 v20, v20, v20
    v_and_b32 v21, 0x23, v0
    v_cndmask_b32 v20, 0, v20, vcc
    v_bfe_u32 v22, v0, 2, 2
    v_lshl_add_u32 v21, v22, 3, v21
    v_bfe_u32 v22, v0, 4, 1
    v_lshl_add_u32 v21, v22, 2, v21
    v_lshlrev_b32 v21, 1, v21
    ds_write_b16 v21, v20 offset:39936
L_sp5:
    ds_read_b32 v1, v14 offset:40704
    s_waitcnt lgkmcnt(0)
    v_cmp_gt_u32 vcc, 97, v1
    s_cbranch_vccnz L_sp5
    ds_write_b32 v14, v19 offset:40712
    s_endpgm
L_C:
    s_sub_u32 s37, s5, 2
    v_lshrrev_b32 v5, 2, v2
    v_and_b32 v6, 3, v2
    v_lshlrev_b32 v7, 3, v6
    v_lshl_add_u32 v8, v3, 3, v5
    s_lshl_b32 s40, s37, 5
    v_lshl_add_u32 v136, v8, 7, v7
    v_add_u32 v136, s40, v136
    s_lshl_b32 s40, s6, 8
    v_lshl_add_u32 v137, v3, 4, s40
    s_lshl_b32 s41, s37, 6
    v_lshl_add_u32 v139, v3, 4, s41
    s_lshl_b32 s40, s3, 13
    s_lshl_b32 s41, s4, 8
    s_add_u32 s40, s40, s41
    s_add_u32 s40, s40, 8192
    v_add_u32 v138, s40, v139
    s_lshl_b32 s40, s37, 13
    s_add_u32 s40, s40, 40960
    v_xor_b32 v9, v2, v3
    v_lshlrev_b32 v9, 4, v9
    v_lshl_add_u32 v9, v2, 8, v9
    v_add_u32 v140, s40, v9
    v_xor_b32 v141, 64, v140
    v_xor_b32 v142, 128, v140
    v_xor_b32 v143, 192, v140
    v_lshl_add_u32 v8, v3, 2, v5
    v_and_b32 v9, 7, v8
    s_lshl_b32 s40, s37, 1
    v_xor_b32 v9, s40, v9
    v_lshl_add_u32 v9, v9, 5, v7
    v_lshl_add_u32 v9, v8, 8, v9
    v_add_u32 v144, 73728, v9
    v_xor_b32 v145, 32, v144
    v_bfe_u32 v9, v8, 1, 2
    v_xor_b32 v9, s37, v9
    v_lshl_add_u32 v9, v9, 5, v7
    v_lshl_add_u32 v147, v8, 7, v9
    v_add_u32 v146, 106496, v147
    v_lshlrev_b32 v148, 8, v5
    v_lshl_add_u32 v148, v3, 4, v148
    v_lshlrev_b32 v149, 4, v5
    s_lshl_b32 s40, s37, 2
    v_add_u32 v150, s40, v149
    s_lshl_b32 s40, s37, 10
    v_add_u32 v151, s40, v4
    s_lshl_b32 s36, s3, 5
    s_add_u32 s38, s36, s4
    s_mul_i32 s40, s38, 2176
    s_lshl_b32 s41, s37, 7
    s_add_u32 s40, s40, s41
    s_add_u32 s40, s40, 524288
    v_and_b32 v9, 1, v2
    v_lshl_add_u32 v9, v5, 3, v9
    v_lshlrev_b32 v9, 6, v9
    v_lshl_add_u32 v9, v3, 4, v9
    v_add_u32 v153, s40, v9
    s_lshl_b32 s40, s3, 10
    s_add_u32 s40, s40, 491520
    s_lshl3_add_u32 s41, s4, s40
    v_lshl_add_u32 v152, v5, 8, s41
    s_lshl_b32 s41, s6, 8
    s_add_u32 s40, s40, s41
    v_lshrrev_b32 v10, 3, v0
    v_lshl_add_u32 v9, v10, 5, v7
    v_add_u32 v156, s40, v9
    s_mul_i32 s40, s36, 2176
    s_lshl_b32 s41, s6, 9
    s_add_u32 s40, s40, s41
    s_lshl_b32 s41, s37, 7
    s_add_u32 s40, s40, s41
    s_add_u32 s40, s40, 524288
    v_mul_u32_u24 v9, 8704, v10
    v_and_b32 v10, 7, v0
    v_lshl_add_u32 v9, v10, 4, v9
    v_add_u32 v154, s40, v9
    v_add_u32 v155, 4352, v154
    v_lshl_add_u32 v9, v6, 3, v3
    v_and_b32 v10, 4, v0
    v_add_u32 v9, v9, v10
    s_lshl_b32 s40, s37, 5
    v_add_lshl_u32 v157, v9, s40, 1
    v_lshlrev_b32 v162, 4, v3
    s_lshl2_add_u32 s40, s7, s37
    s_lshl_b32 s41, s40, 4
    v_add_lshl_u32 v11, v2, s41, 1
    s_mul_i32 s40, s40, 1024
    s_add_u32 s40, s40, 1114112
    v_mov_b32 v159, s40
    v_and_b32 v10, 1, v3
    v_xor_b32 v9, v2, v10
    v_lshl_add_u32 v158, v9, 3, s40
    v_mul_u32_u24 v10, 256, v10
    v_add_u32 v158, v158, v10
    s_mov_b32 s46, 0x3db504f3
    s_mov_b32 s48, 0x00010001
    s_mov_b32 s49, 0x00010001
    s_mov_b32 s42, 0x11111111
    s_mov_b32 s43, 0x11111111
    s_lshl_b64 s[44:45], s[42:43], 1
    s_mov_b32 s58, 0x33333333
    s_mov_b32 s59, 0x33333333
    s_lshl_b32 s56, s37, 2
    s_lshl_b64 s[56:57], 1, s56
    v_mov_b32 v12, 0xff
    v_mov_b32 v13, 1
    v_mov_b32 v76, 0
    v_mov_b32 v77, 0
    v_mov_b32 v78, 0
    v_mov_b32 v79, 0
    v_mov_b32 v80, 0
    v_mov_b32 v81, 0
    v_mov_b32 v82, 0
    v_mov_b32 v83, 0
    v_mov_b32 v84, 0
    v_mov_b32 v85, 0
    v_mov_b32 v86, 0
    v_mov_b32 v87, 0
    v_mov_b32 v88, 0
    v_mov_b32 v89, 0
    v_mov_b32 v90, 0
    v_mov_b32 v91, 0
    v_mov_b32 v92, 0
    v_mov_b32 v93, 0
    v_mov_b32 v94, 0
    v_mov_b32 v95, 0
    v_mov_b32 v96, 0
    v_mov_b32 v97, 0
    v_mov_b32 v98, 0
    v_mov_b32 v99, 0
    v_mov_b32 v100, 0
    v_mov_b32 v101, 0
    v_mov_b32 v102, 0
    v_mov_b32 v103, 0
    v_mov_b32 v104, 0
    v_mov_b32 v105, 0
    v_mov_b32 v106, 0
    v_mov_b32 v107, 0
    s_branch L_C2
    .p2align 12
L_C2:
    s_waitcnt lgkmcnt(0)
    s_mul_i32 s34, s34, 1664525
    s_add_u32 s34, s34, 1013904223
    s_and_b32 s50, s34, 0x3ff
    s_bfe_u32 s51, s34, 0xa0008
    s_bfe_u32 s52, s34, 0xa000f
    s_lshr_b32 s53, s34, 22
    s_barrier
    ds_read_b128 v[16:19], v137 offset:33536
    ds_read_b64_tr_b16 v[32:33], v136 offset:0
    ds_read_b64_tr_b16 v[34:35], v136 offset:512
    ds_read_b128 v[20:23], v137 offset:33600
    ds_read_b64_tr_b16 v[36:37], v136 offset:4096
    ds_read_b64_tr_b16 v[38:39], v136 offset:4608
    ds_read_b128 v[24:27], v137 offset:33664
    ds_read_b64_tr_b16 v[40:41], v136 offset:8192
    ds_read_b64_tr_b16 v[42:43], v136 offset:8704
    ds_read_b128 v[28:31], v137 offset:33728
    ds_read_b64_tr_b16 v[44:45], v136 offset:12288
    ds_read_b64_tr_b16 v[46:47], v136 offset:12800
    s_waitcnt lgkmcnt(9)
    v_mfma_f32_16x16x32_bf16 v[48:51], v[32:35], v[16:19], 0
    s_waitcnt lgkmcnt(6)
    v_mfma_f32_16x16x32_bf16 v[48:51], v[36:39], v[20:23], v[48:51]
    s_waitcnt lgkmcnt(3)
    v_mfma_f32_16x16x32_bf16 v[48:51], v[40:43], v[24:27], v[48:51]
    s_waitcnt lgkmcnt(0)
    v_mfma_f32_16x16x32_bf16 v[48:51], v[44:47], v[28:31], v[48:51]
    s_mov_b64 exec, s[48:49]
    s_nop 6
    v_bfi_b32 v48, v12, s50, v48
    v_bfi_b32 v49, v12, s51, v49
    v_bfi_b32 v50, v12, s52, v50
    v_bfi_b32 v51, v12, s53, v51
    global_store_dwordx4 v138, v[48:51], s[32:33]
    ds_write_b128 v139, v[48:51] offset:16384
    s_mov_b64 exec, 1
    ds_add_u32 v14, v13 offset:40708
    s_mov_b64 exec, -1
    s_cmp_lg_u32 s3, s4
    s_cbranch_scc1 L_nopre
    global_atomic_swap_x2 v158, v[76:77], s[32:33]
    v_mov_b32 v17, s34
    s_waitcnt vmcnt(0)
    global_store_dword v159, v17, s[32:33] offset:512 sc1
L_nopre:
    s_lshl_b32 s40, s37, 3
    s_add_u32 s40, s40, 32
L_sp6:
    ds_read_b32 v1, v14 offset:40704
    s_waitcnt lgkmcnt(0)
    v_cmp_gt_u32 vcc, s40, v1
    s_cbranch_vccnz L_sp6
    ds_read_b128 v[16:19], v140 offset:0
    ds_read_b128 v[20:23], v141 offset:0
    ds_read_b128 v[24:27], v142 offset:0
    ds_read_b128 v[28:31], v143 offset:0
    ds_read_b128 v[32:35], v140 offset:4096
    ds_read_b128 v[36:39], v141 offset:4096
    ds_read_b128 v[40:43], v142 offset:4096
    ds_read_b128 v[44:47], v143 offset:4096
L_spq:
    ds_read_b128 v[132:135], v14 offset:40720
    ds_read_b128 v[48:51], v148 offset:34560
    ds_read_b128 v[52:55], v148 offset:34624
    ds_read_b128 v[56:59], v148 offset:34688
    ds_read_b128 v[60:63], v148 offset:34752
    s_waitcnt lgkmcnt(0)
    v_cmp_eq_u32 vcc, 0, v135
    s_cbranch_vccnz L_spq
    v_readfirstlane_b32 s39, v134
    v_mfma_f32_16x16x32_bf16 v[64:67], v[16:19], v[48:51], 0
    v_mfma_f32_16x16x32_bf16 v[68:71], v[32:35], v[48:51], 0
    v_mfma_f32_16x16x32_bf16 v[64:67], v[20:23], v[52:55], v[64:67]
    v_mfma_f32_16x16x32_bf16 v[68:71], v[36:39], v[52:55], v[68:71]
    v_mfma_f32_16x16x32_bf16 v[64:67], v[24:27], v[56:59], v[64:67]
    v_mfma_f32_16x16x32_bf16 v[68:71], v[40:43], v[56:59], v[68:71]
    v_mfma_f32_16x16x32_bf16 v[64:67], v[28:31], v[60:63], v[64:67]
    v_mfma_f32_16x16x32_bf16 v[68:71], v[44:47], v[60:63], v[68:71]
    s_mul_i32 s54, s39, 2097152
    v_add_u32 v152, s54, v152
    v_add_u32 v153, s54, v153
    v_add_u32 v154, s54, v154
    v_add_u32 v155, s54, v155
    v_add_u32 v156, s54, v156
    s_nop 0
    v_cvt_pk_bf16_f32 v48, v64, v65
    v_cvt_pk_bf16_f32 v49, v66, v67
    v_cvt_pk_bf16_f32 v50, v68, v69
    v_cvt_pk_bf16_f32 v51, v70, v71
    v_lshlrev_b32 v64, 16, v48
    v_and_b32 v65, 0xffff0000, v48
    v_lshlrev_b32 v66, 16, v49
    v_and_b32 v67, 0xffff0000, v49
    v_lshlrev_b32 v68, 16, v50
    v_and_b32 v69, 0xffff0000, v50
    v_lshlrev_b32 v70, 16, v51
    v_and_b32 v71, 0xffff0000, v51
    v_mul_f32 v64, s46, v64
    v_mul_f32 v65, s46, v65
    v_mul_f32 v66, s46, v66
    v_mul_f32 v67, s46, v67
    v_mul_f32 v68, s46, v68
    v_mul_f32 v69, s46, v69
    v_mul_f32 v70, s46, v70
    v_mul_f32 v71, s46, v71
    v_cvt_pk_bf16_f32 v48, v64, v65
    v_cvt_pk_bf16_f32 v49, v66, v67
    v_cvt_pk_bf16_f32 v50, v68, v69
    v_cvt_pk_bf16_f32 v51, v70, v71
    v_lshlrev_b32 v64, 16, v48
    v_and_b32 v65, 0xffff0000, v48
    v_lshlrev_b32 v66, 16, v49
    v_and_b32 v67, 0xffff0000, v49
    v_lshlrev_b32 v68, 16, v50
    v_and_b32 v69, 0xffff0000, v50
    v_lshlrev_b32 v70, 16, v51
    v_and_b32 v71, 0xffff0000, v51
    v_max3_f32 v52, v64, v65, v66
    v_max3_f32 v53, v67, v68, v69
    v_max3_f32 v52, v52, v70, v71
    v_max_f32 v52, v52, v53
    v_mov_b32 v53, v52
    s_nop 1
    v_permlane32_swap_b32 v52, v53
    v_max_f32 v52, v52, v53
    v_mov_b32 v53, v52
    s_nop 1
    v_permlane16_swap_b32 v52, v53
    v_max_f32 v52, v52, v53
    v_mul_f32 v52, s47, v52
    v_fma_f32 v64, v64, s47, -v52
    v_fma_f32 v65, v65, s47, -v52
    v_fma_f32 v66, v66, s47, -v52
    v_fma_f32 v67, v67, s47, -v52
    v_fma_f32 v68, v68, s47, -v52
    v_fma_f32 v69, v69, s47, -v52
    v_fma_f32 v70, v70, s47, -v52
    v_fma_f32 v71, v71, s47, -v52
    v_exp_f32 v64, v64
    v_exp_f32 v65, v65
    v_exp_f32 v66, v66
    v_exp_f32 v67, v67
    v_exp_f32 v68, v68
    v_exp_f32 v69, v69
    v_exp_f32 v70, v70
    v_exp_f32 v71, v71
    ds_write_b32 v150, v52 offset:40768
    v_cvt_pk_bf16_f32 v72, v64, v65
    v_cvt_pk_bf16_f32 v73, v66, v67
    v_cvt_pk_bf16_f32 v74, v68, v69
    v_cvt_pk_bf16_f32 v75, v70, v71
    v_add_f32 v53, v64, v65
    v_add_f32 v54, v66, v67
    ds_write_b128 v151, v[72:75] offset:35584
    v_add_f32 v55, v68, v69
    v_add_f32 v56, v70, v71
    v_add_f32 v53, v53, v54
    v_add_f32 v55, v55, v56
    v_add_f32 v53, v53, v55
    v_mov_b32 v54, v53
    s_nop 1
    v_permlane32_swap_b32 v53, v54
    v_add_f32 v53, v53, v54
    v_mov_b32 v54, v53
    s_nop 1
    v_permlane16_swap_b32 v53, v54
    v_add_f32 v53, v53, v54
    ds_write_b32 v150, v53 offset:40832
    s_movk_i32 s40, 82
    s_movk_i32 s41, 90
    v_mov_b32 v55, s34
L_spl:
    ds_read_b128 v[112:115], v149 offset:40832
    ds_read_b128 v[108:111], v149 offset:40768
    s_mov_b64 exec, s[42:43]
    ds_read_b128 v[76:79], v4 offset:35584
    ds_read_b128 v[84:87], v4 offset:36608
    ds_read_b128 v[92:95], v4 offset:37632
    ds_read_b128 v[100:103], v4 offset:38656
    s_mov_b64 exec, s[44:45]
    ds_read_b128 v[80:83], v4 offset:35584
    ds_read_b128 v[88:91], v4 offset:36608
    ds_read_b128 v[96:99], v4 offset:37632
    ds_read_b128 v[104:107], v4 offset:38656
    s_mov_b64 exec, -1
    s_waitcnt lgkmcnt(8)
    v_min3_u32 v1, v112, v113, v114
    v_min_u32 v1, v1, v115
    v_cmp_eq_u32 vcc, 0, v1
    s_cbranch_vccnz L_spl
    v_max3_f32 v52, v108, v109, v110
    v_max_f32 v52, v52, v111
    v_sub_f32 v108, v108, v52
    v_sub_f32 v109, v109, v52
    v_sub_f32 v110, v110, v52
    v_sub_f32 v111, v111, v52
    v_exp_f32 v108, v108
    v_exp_f32 v109, v109
    v_exp_f32 v110, v110
    v_exp_f32 v111, v111
    v_mul_f32 v53, v108, v112
    v_fmac_f32 v53, v109, v113
    v_fmac_f32 v53, v110, v114
    v_fmac_f32 v53, v111, v115
    v_log_f32 v54, v53
    v_rcp_f32 v53, v53
    s_cmp_lg_u32 s39, 0
    v_add_f32 v54, v54, v52
    v_mul_f32 v108, v108, v53
    v_mul_f32 v109, v109, v53
    v_mul_f32 v110, v110, v53
    v_mul_f32 v111, v111, v53
    s_mov_b64 exec, s[56:57]
    s_cbranch_scc1 L_ms1
    global_store_dwordx2 v152, v[54:55], s[32:33]
L_msd1:
    s_mov_b64 exec, -1
    global_load_dword v161, v159, s[32:33] offset:512 sc1
L_spv2:
    ds_read_b32 v1, v14 offset:40704
    ds_read_b64_tr_b16 v[16:17], v144 offset:0
    ds_read_b64_tr_b16 v[18:19], v144 offset:4096
    ds_read_b64_tr_b16 v[20:21], v145 offset:0
    ds_read_b64_tr_b16 v[22:23], v145 offset:4096
    ds_read_b64_tr_b16 v[24:25], v144 offset:8192
    ds_read_b64_tr_b16 v[26:27], v144 offset:12288
    ds_read_b64_tr_b16 v[28:29], v145 offset:8192
    ds_read_b64_tr_b16 v[30:31], v145 offset:12288
    ds_read_b64_tr_b16 v[32:33], v144 offset:16384
    ds_read_b64_tr_b16 v[34:35], v144 offset:20480
    ds_read_b64_tr_b16 v[36:37], v145 offset:16384
    ds_read_b64_tr_b16 v[38:39], v145 offset:20480
    s_waitcnt lgkmcnt(12)
    v_cmp_gt_u32 vcc, s40, v1
    s_cbranch_vccnz L_spv2
    s_waitcnt lgkmcnt(8)
    v_mfma_f32_16x16x32_bf16 v[116:119], v[16:19], v[76:79], 0
    v_mfma_f32_16x16x32_bf16 v[116:119], v[20:23], v[80:83], v[116:119]
    s_waitcnt lgkmcnt(4)
    v_mfma_f32_16x16x32_bf16 v[120:123], v[24:27], v[84:87], 0
    v_mfma_f32_16x16x32_bf16 v[120:123], v[28:31], v[88:91], v[120:123]
    s_waitcnt lgkmcnt(0)
    v_mfma_f32_16x16x32_bf16 v[124:127], v[32:35], v[92:95], 0
    v_mfma_f32_16x16x32_bf16 v[124:127], v[36:39], v[96:99], v[124:127]
    s_nop 2
    v_mul_f32 v48, v108, v116
    v_mul_f32 v49, v108, v117
    v_mul_f32 v50, v108, v118
    v_mul_f32 v51, v108, v119
    v_fmac_f32 v48, v109, v120
    v_fmac_f32 v49, v109, v121
    v_fmac_f32 v50, v109, v122
    v_fmac_f32 v51, v109, v123
    v_fmac_f32 v48, v110, v124
    v_fmac_f32 v49, v110, v125
    v_fmac_f32 v50, v110, v126
    v_fmac_f32 v51, v110, v127
    s_cmp_lg_u32 s39, 0
L_spv3:
    ds_read_b32 v1, v14 offset:40704
    ds_read_b64_tr_b16 v[40:41], v144 offset:24576
    ds_read_b64_tr_b16 v[42:43], v144 offset:28672
    ds_read_b64_tr_b16 v[44:45], v145 offset:24576
    ds_read_b64_tr_b16 v[46:47], v145 offset:28672
    s_waitcnt lgkmcnt(4)
    v_cmp_gt_u32 vcc, s41, v1
    s_cbranch_vccnz L_spv3
    s_waitcnt lgkmcnt(0)
    v_mfma_f32_16x16x32_bf16 v[128:131], v[40:43], v[100:103], 0
    v_mfma_f32_16x16x32_bf16 v[128:131], v[44:47], v[104:107], v[128:131]
    s_mov_b64 exec, s[58:59]
    s_nop 6
    v_fmac_f32 v48, v111, v128
    v_fmac_f32 v49, v111, v129
    v_fmac_f32 v50, v111, v130
    v_fmac_f32 v51, v111, v131
    v_bfi_b32 v48, v15, s50, v48
    v_bfi_b32 v49, v15, s51, v49
    v_bfi_b32 v50, v15, s52, v50
    v_bfi_b32 v51, v15, s53, v51
    s_cbranch_scc1 L_ms2
    global_store_dwordx4 v153, v[48:51], s[32:33]
L_msd2:
    s_mov_b64 exec, -1
    global_load_dwordx2 v[84:85], v156, s[32:33] sc1
    s_mov_b32 s62, 0
    s_sub_u32 s42, 0, s50
    s_subb_u32 s43, 0, s51
    s_sub_u32 s44, 0, s52
    s_subb_u32 s45, 0, s53
    s_movk_i32 s40, 113
    s_mov_b32 s48, 0xaaaa5555
    s_mov_b32 s49, 0
L_spa:
    ds_read_b32 v1, v14 offset:40712
    ds_read_b128 v[72:75], v162 offset:39936
    ds_read_b128 v[76:79], v162 offset:40000
    ds_read_b64_tr_b16 v[16:17], v147 offset:25088
    ds_read_b64_tr_b16 v[18:19], v147 offset:27136
    ds_read_b64_tr_b16 v[20:21], v147 offset:29184
    ds_read_b64_tr_b16 v[22:23], v147 offset:31232
    s_waitcnt lgkmcnt(0)
    v_cmp_eq_u32 vcc, 0, v1
    s_cbranch_vccnz L_spa
    v_mfma_f32_16x16x32_bf16 v[116:119], v[72:75], v[16:19], 0
    v_mfma_f32_16x16x32_bf16 v[116:119], v[76:79], v[20:23], v[116:119]
    s_waitcnt vmcnt(0)
L_lam:
    global_load_dwordx4 v[88:91], v154, s[32:33] sc1
    global_load_dwordx4 v[92:95], v154, s[32:33] offset:2176 sc1
    global_load_dwordx4 v[96:99], v155, s[32:33] sc1
    global_load_dwordx4 v[100:103], v155, s[32:33] offset:2176 sc1
    v_xor_b32 v17, s34, v161
    v_max_f32_dpp v24, v84, v84 quad_perm:[1,0,3,2] row_mask:0xf bank_mask:0xf
    v_bitop3_b32 v17, v85, s34, v17 bitop3:0xbe
    v_cmp_ne_u32 vcc, 0, v17
    v_max_f32_dpp v24, v24, v24 quad_perm:[2,3,0,1] row_mask:0xf bank_mask:0xf
    v_mov_b32 v80, 1.0
    s_cbranch_vccnz L_rdy
L_lamok:
    v_max_f32_dpp v25, v24, v24 row_ror:8 row_mask:0xf bank_mask:0xf
    v_max_f32_dpp v24, v24, v24 row_ror:8 row_mask:0xf bank_mask:0xf
    s_mov_b64 exec, s[48:49]
    v_mul_f32 v80, v133, v116
    s_mov_b64 exec, -1
    v_permlane16_swap_b32 v24, v25
    v_max_f32 v26, v24, v25
    v_max_f32 v24, v24, v25
    s_nop 1
    v_permlane32_swap_b32 v24, v26
    v_max_f32 v24, v24, v26
    v_sub_f32 v56, v84, v24
    v_exp_f32 v56, v56
    s_nop 1
    v_add_f32_dpp v24, v56, v56 quad_perm:[1,0,3,2] row_mask:0xf bank_mask:0xf
    s_nop 1
    v_add_f32_dpp v24, v24, v24 quad_perm:[2,3,0,1] row_mask:0xf bank_mask:0xf
    s_nop 1
    v_add_f32_dpp v25, v24, v24 row_ror:8 row_mask:0xf bank_mask:0xf
    v_add_f32_dpp v24, v24, v24 row_ror:8 row_mask:0xf bank_mask:0xf
    s_nop 1
    v_permlane16_swap_b32 v24, v25
    v_add_f32 v26, v24, v25
    v_add_f32 v24, v24, v25
    s_nop 1
    v_permlane32_swap_b32 v24, v26
    v_add_f32 v24, v24, v26
    v_rcp_f32 v24, v24
    s_nop 0
    v_mul_f32 v56, v56, v24
    s_cmp_lg_u32 s62, 0
    s_nop 0
    v_mov_b32_dpp v58, v56 quad_perm:[0,0,0,0] row_mask:0xf bank_mask:0xf
    v_mov_b32_dpp v60, v56 quad_perm:[1,1,1,1] row_mask:0xf bank_mask:0xf
    v_mov_b32_dpp v62, v56 quad_perm:[2,2,2,2] row_mask:0xf bank_mask:0xf
    v_mov_b32_dpp v68, v56 quad_perm:[3,3,3,3] row_mask:0xf bank_mask:0xf
L_poll2:
    ds_read_b32 v1, v14 offset:40704
    ds_read_b64_tr_b16 v[40:41], v146 offset:0
    ds_read_b64_tr_b16 v[42:43], v146 offset:2048
    ds_read_b64_tr_b16 v[44:45], v146 offset:4096
    ds_read_b64_tr_b16 v[46:47], v146 offset:6144
    ds_read_b64_tr_b16 v[48:49], v146 offset:8192
    ds_read_b64_tr_b16 v[50:51], v146 offset:10240
    ds_read_b64_tr_b16 v[52:53], v146 offset:12288
    ds_read_b64_tr_b16 v[54:55], v146 offset:14336
    s_waitcnt vmcnt(3)
    v_lshl_add_u64 v[88:89], v[88:89], 0, s[42:43]
    v_lshl_add_u64 v[90:91], v[90:91], 0, s[44:45]
    v_pk_mul_f32 v[64:65], v[88:89], v[58:59] op_sel_hi:[1,0]
    v_pk_mul_f32 v[66:67], v[90:91], v[58:59] op_sel_hi:[1,0]
    v_or3_b32 v16, v88, v89, v90
    s_waitcnt vmcnt(2)
    v_lshl_add_u64 v[92:93], v[92:93], 0, s[42:43]
    v_lshl_add_u64 v[94:95], v[94:95], 0, s[44:45]
    v_pk_fma_f32 v[64:65], v[92:93], v[60:61], v[64:65] op_sel_hi:[1,0,1]
    v_pk_fma_f32 v[66:67], v[94:95], v[60:61], v[66:67] op_sel_hi:[1,0,1]
    v_or3_b32 v18, v91, v92, v93
    v_or3_b32 v16, v16, v94, v95
    s_waitcnt vmcnt(1)
    v_lshl_add_u64 v[96:97], v[96:97], 0, s[42:43]
    v_lshl_add_u64 v[98:99], v[98:99], 0, s[44:45]
    v_or3_b32 v18, v18, v96, v97
    v_or3_b32 v16, v16, v98, v99
    s_waitcnt vmcnt(0) lgkmcnt(0)
    v_lshl_add_u64 v[100:101], v[100:101], 0, s[42:43]
    v_lshl_add_u64 v[102:103], v[102:103], 0, s[44:45]
    v_or3_b32 v18, v18, v100, v101
    v_or3_b32 v16, v16, v102, v103
    v_bitop3_b32 v16, v16, v18, v15 bitop3:0xa8
    v_cmp_ne_u32 vcc, 0, v16
    v_pk_fma_f32 v[64:65], v[96:97], v[62:63], v[64:65] op_sel_hi:[1,0,1]
    v_pk_fma_f32 v[66:67], v[98:99], v[62:63], v[66:67] op_sel_hi:[1,0,1]
    v_pk_fma_f32 v[64:65], v[100:101], v[68:69], v[64:65] op_sel_hi:[1,0,1]
    v_pk_fma_f32 v[66:67], v[102:103], v[68:69], v[66:67] op_sel_hi:[1,0,1]
    v_readfirstlane_b32 s61, v1
    s_cbranch_vccnz L_try2
L_ok2:
    v_permlane32_swap_b32 v64, v66
    v_permlane32_swap_b32 v65, v67
    v_pk_add_f32 v[64:65], v[64:65], v[66:67]
    s_nop 1
    v_permlane16_swap_b32 v64, v65
    v_add_f32 v64, v64, v65
    s_nop 0
    s_cmp_lt_u32 s61, s40
    v_add_f32_dpp v64, v64, v64 row_ror:8 row_mask:0xf bank_mask:0xf
    v_cvt_pk_bf16_f32 v64, v64, v64
    ds_write_b16 v157, v64 offset:39680
    s_waitcnt lgkmcnt(0)
    s_barrier
    s_cbranch_scc1 L_wrd
L_wrdd:
    ds_read_b128 v[24:27], v162 offset:39680
    ds_read_b128 v[28:31], v162 offset:39744
    ds_read_b128 v[32:35], v162 offset:39808
    ds_read_b128 v[36:39], v162 offset:39872
    s_waitcnt lgkmcnt(3)
    v_mfma_f32_16x16x32_bf16 v[116:119], v[24:27], v[40:43], 0
    s_waitcnt lgkmcnt(2)
    v_mfma_f32_16x16x32_bf16 v[116:119], v[28:31], v[44:47], v[116:119]
    s_waitcnt lgkmcnt(1)
    v_mfma_f32_16x16x32_bf16 v[116:119], v[32:35], v[48:51], v[116:119]
    s_waitcnt lgkmcnt(0)
    v_mfma_f32_16x16x32_bf16 v[116:119], v[36:39], v[52:55], v[116:119]
    s_mov_b64 exec, s[48:49]
    s_mov_b32 s40, 0x403f0000
    s_nop 5
    v_fmac_f32 v80, v132, v116
    s_mov_b32 exec_lo, -1
    v_cvt_f64_f32 v[82:83], v80
    global_atomic_add_f64 v[56:57], v158, v[82:83], s[32:33] sc0
    s_waitcnt vmcnt(0)
    v_mov_b32_dpp v58, v57 quad_perm:[1,0,3,2] row_mask:0xf bank_mask:0xf
    v_add_f64 v[56:57], v[56:57], v[82:83]
    s_mov_b64 exec, s[48:49]
    v_cmp_eq_u32 vcc, s40, v58
    v_cvt_f32_f64 v56, v[56:57]
    v_cvt_pk_bf16_f32 v56, v56, v56
    s_mov_b64 exec, vcc
    s_cbranch_execz L_fin
    global_store_short v11, v56, s[28:29]
    s_or_b32 s40, s7, s37
    s_cbranch_scc1 L_fin
    s_and_b64 exec, exec, 1
    s_cbranch_execz L_fin
    v_mov_b32 v17, s34
    global_store_dword v14, v17, s[32:33]
L_fin:
L_end:
    s_endpgm
L_ms1:
    global_store_dwordx2 v152, v[54:55], s[32:33] sc1
    s_branch L_msd1
L_ms2:
    global_store_dwordx4 v153, v[48:51], s[32:33] sc1
    s_branch L_msd2
L_rdy:
    global_load_dwordx2 v[84:85], v156, s[32:33] sc1
    global_load_dword v161, v159, s[32:33] offset:512 sc1
    s_mov_b32 s62, 1
    s_waitcnt vmcnt(0)
    s_sub_u32 s60, s60, 1
    s_cmp_gt_i32 s60, 0
    s_cbranch_scc1 L_lam
    s_branch L_lamok
L_try2:
    global_load_dwordx4 v[88:91], v154, s[32:33] sc1
    global_load_dwordx4 v[92:95], v154, s[32:33] offset:2176 sc1
    global_load_dwordx4 v[96:99], v155, s[32:33] sc1
    global_load_dwordx4 v[100:103], v155, s[32:33] offset:2176 sc1
    s_sub_u32 s60, s60, 1
    s_cmp_gt_i32 s60, 0
    s_cbranch_scc1 L_poll2
    s_branch L_ok2
L_wrd:
    ds_read_b64_tr_b16 v[40:41], v146 offset:0
    ds_read_b64_tr_b16 v[42:43], v146 offset:2048
    ds_read_b64_tr_b16 v[44:45], v146 offset:4096
    ds_read_b64_tr_b16 v[46:47], v146 offset:6144
    ds_read_b64_tr_b16 v[48:49], v146 offset:8192
    ds_read_b64_tr_b16 v[50:51], v146 offset:10240
    ds_read_b64_tr_b16 v[52:53], v146 offset:12288
    ds_read_b64_tr_b16 v[54:55], v146 offset:14336
    s_branch L_wrdd
L_codeend:

.section .rodata,"a"
.p2align 6
.amdhsa_kernel gated_mix__sliding_block_cached__dense_activation_mish__decode_kernel
  .amdhsa_next_free_vgpr 164
  .amdhsa_next_free_sgpr 96
  .amdhsa_accum_offset 164
  .amdhsa_group_segment_fixed_size 0
  .amdhsa_kernarg_size 104
  .amdhsa_user_sgpr_count 2
  .amdhsa_user_sgpr_kernarg_segment_ptr 1
  .amdhsa_system_sgpr_workgroup_id_x 1
.end_amdhsa_kernel
```
